```python
import torch

def _softmax(x, axis=-1):
    return torch.softmax(x, dim=axis)
def _gelu(x):
    return torch.nn.functional.gelu(x, approximate="tanh")
def _silu(x):
    return torch.nn.functional.silu(x)
def _sigmoid(x):
    return torch.sigmoid(x)
def _layernorm(x, axis=-1, eps=1e-5):
    m = x.mean(dim=axis, keepdim=True)
    v = x.var(dim=axis, keepdim=True, unbiased=False)
    return (x - m) / torch.sqrt(v + eps)
def _scatter_add(tgt, idx, src, axis=0):
    return tgt.clone().index_add_(axis, idx, src)
def _segment_sum(src, seg, n):
    out = torch.zeros((n,) + src.shape[1:], dtype=src.dtype)
    return out.index_add_(0, seg, src)
def _pad(x, pw):
    flat = tuple(v for pair in reversed(pw) for v in pair)
    return torch.nn.functional.pad(x, flat)

kernel_name = 'standalone__paged_block_table_kv_radixattention__decode'

def setup_inputs():

    _w = (lambda a: (lambda t: t.to(torch.bfloat16) if t.is_floating_point() else t)(torch.as_tensor(a)))
    B, H, Hkv, Dh = 2, 32, 16, 128
    Lk = 4096
    bs = 16
    nb = max(2, Lk // bs)
    P = max(1, nb // 2)
    n_phys = P + B * (nb - P)
    shared = torch.arange(P, dtype=torch.int64)
    priv = P + torch.arange(B * (nb - P), dtype=torch.int64).reshape(B, nb - P)
    bt = torch.cat([torch.tile(shared[None, :], (B, 1)), priv], dim=1)
    ctx = nb * bs - (torch.arange(1, B + 1, dtype=torch.int64) * 2654435761) % max(1, (nb * bs - P * bs) // 2)
    return {
        "q": _w((lambda *s: torch.randn(*s, dtype=torch.bfloat16) * 0.8)(B, H, Dh)),
        "k_cache": _w((lambda *s: torch.randn(*s, dtype=torch.bfloat16) * 0.8)(n_phys, bs, Hkv, Dh)),
        "v_cache": _w((lambda *s: torch.randn(*s, dtype=torch.bfloat16) * 0.05)(n_phys, bs, Hkv, Dh)),
        "block_table": _w(bt.to(torch.int64)),
        "ctx_lens": _w(torch.as_tensor(ctx).to(torch.int64)),
    }

def reference(q, k_cache, v_cache, block_table, ctx_lens):
    B, H, Dh = q.shape
    n_phys, bs, Hkv, _ = k_cache.shape
    nb = block_table.shape[1]
    Lk = nb * bs
    rep = H // Hkv
    k = k_cache[block_table].reshape(B, Lk, Hkv, Dh)
    v = v_cache[block_table].reshape(B, Lk, Hkv, Dh)
    k = (lambda x, n, axis: torch.repeat_interleave(x, n, dim=axis))(k, rep, axis=2)
    v = (lambda x, n, axis: torch.repeat_interleave(x, n, dim=axis))(v, rep, axis=2)
    scores = torch.einsum("bhd,bkhd->bhk", q, k) * (Dh ** -0.5)
    pos = torch.arange(Lk)
    valid = pos[None, :] < ctx_lens[:, None]
    scores = torch.where(valid[:, None, :], scores, -1e9)
    p = _softmax(scores, axis=-1)
    return torch.einsum("bhk,bkhd->bhd", p, v)
```

```asm
; @launch grid=(256,1,1) block=(704,1,1) lds=23104
.amdgcn_target "amdgcn-amd-amdhsa--gfx950"
.text
.globl standalone__paged_block_table_kv_radixattention__decode_kernel
.p2align 12
.p2align 8
.type standalone__paged_block_table_kv_radixattention__decode_kernel,@function
standalone__paged_block_table_kv_radixattention__decode_kernel:
  s_load_dwordx16 s[4:19], s[0:1], 0
  s_getpc_b64 s[82:83]
  v_lshrrev_b32 v14, 6, v0
  v_and_b32 v1, 63, v0
  v_readfirstlane_b32 s84, v14
  s_cmp_ge_u32 s2, 256
  s_cbranch_scc1 L_end
  s_and_b32 s90, s2, 7
  s_lshl_b32 s90, s90, 3
  s_mov_b32 s92, 0x704e0e30
  s_mov_b32 s93, 0xefceb08e
  s_lshr_b64 s[92:93], s[92:93], s90
  s_and_b32 s79, s92, 31
  s_bfe_u32 s77, s92, 0x30005
  s_lshl_b32 s77, s77, 1
  s_lshr_b32 s91, s2, 3
  s_sub_u32 s86, s91, s79
  s_sub_u32 s80, 32, s79
  s_cmp_ge_u32 s91, s79
  s_cselect_b32 s86, s86, s91
  s_cselect_b32 s80, s80, s79
  s_mov_b32 s92, 0x4c57574c
  s_mov_b32 s93, 0x51574c57
  s_cselect_b32 s92, 0x4c44444c, s92
  s_cselect_b32 s93, 0x48444c44, s93
  s_addc_u32 s85, s77, 0
  s_lshl_b32 s91, s85, 8
  s_mul_i32 s81, s2, 2304
  s_cmp_eq_u32 s84, 10
  s_cbranch_scc1 L_helper
  s_lshr_b64 s[92:93], s[92:93], s90
  s_and_b32 s93, s92, 0xff
  s_mul_i32 s92, s93, s86
  s_add_u32 s76, s93, 9
  s_mul_i32 s76, s76, 6554
  s_lshr_b32 s76, s76, 16
  s_add_u32 s93, s93, s92
  s_min_u32 s93, s93, 1212
  s_mul_i32 s75, s84, s76
  s_add_u32 s94, s75, s92
  s_add_u32 s95, s94, s76
  s_min_u32 s93, s93, s95
  v_add_u32 v8, s94, v1
  v_add_u32 v9, 108, v8
  v_cmp_gt_u32 vcc, 916, v8
  v_lshrrev_b32 v26, 4, v1
  v_and_b32 v3, 15, v1
  v_cndmask_b32 v9, v9, v8, vcc
  v_cmp_gt_u32 vcc, s93, v8
  v_lshl_add_u32 v9, v9, 14, s91
  v_mov_b32 v10, 25165824
  v_cndmask_b32 v9, v10, v9, vcc
  v_and_b32 v14, 3, v1
  v_lshrrev_b32 v15, 2, v3
  v_readlane_b32 s32, v9, 0
  v_readlane_b32 s33, v9, 1
  v_readlane_b32 s34, v9, 2
  v_readlane_b32 s35, v9, 3
  v_readlane_b32 s36, v9, 4
  v_readlane_b32 s37, v9, 5
  v_readlane_b32 s38, v9, 6
  v_readlane_b32 s39, v9, 7
  v_readlane_b32 s40, v9, 8
  v_lshlrev_b32 v4, 6, v26
  v_lshl_add_u32 v4, v14, 4, v4
  v_lshrrev_b32 v27, 3, v3
  v_and_b32 v12, 1, v15
  v_lshl_add_u32 v12, v12, 8, v4
  v_lshl_add_u32 v12, v27, 13, v12
  s_lshl_b32 s90, s85, 9
  v_add_u32 v12, s90, v12
  v_lshl_add_u32 v4, v15, 12, v4
  s_mov_b32 s22, 25165824
  s_mov_b32 s23, 0x20000
  s_waitcnt lgkmcnt(0)
  s_mov_b64 s[20:21], s[6:7]
  global_load_dwordx4 v[16:19], v12, s[4:5]
  buffer_load_dwordx4 v[84:87], v4, s[20:23], s32 offen nt
  buffer_load_dwordx4 v[88:91], v4, s[20:23], s33 offen nt
  buffer_load_dwordx4 v[92:95], v4, s[20:23], s34 offen nt
  buffer_load_dwordx4 v[96:99], v4, s[20:23], s35 offen nt
  buffer_load_dwordx4 v[100:103], v4, s[20:23], s36 offen nt
  buffer_load_dwordx4 v[104:107], v4, s[20:23], s37 offen nt
  buffer_load_dwordx4 v[108:111], v4, s[20:23], s38 offen nt
  buffer_load_dwordx4 v[112:115], v4, s[20:23], s39 offen nt
  buffer_load_dwordx4 v[116:119], v4, s[20:23], s40 offen nt
  s_branch L_comp2
L_helper:
  s_setprio 3
  s_memrealtime s[60:61]
  v_lshlrev_b32 v2, 7, v1
  s_mov_b32 exec_hi, 0xff
  global_load_dword v3, v2, s[82:83]
  s_mov_b64 exec, -1
  v_lshlrev_b32 v4, 4, v1
  v_lshlrev_b32 v6, 2, v1
  v_mov_b32 v7, 0xee013f39
  v_cmp_gt_u32 vcc, 16, v1
  v_mov_b32 v8, 0
  v_cvt_f32_u32 v10, s80
  v_cndmask_b32 v7, 0, v7, vcc
  v_rcp_f32 v10, v10
  ds_write_b32 v6, v7 offset:22592
  s_mov_b32 s69, 0
  s_waitcnt lgkmcnt(0)
  global_load_dwordx4 v[12:15], v4, s[10:11]
  global_load_dwordx4 v[16:19], v4, s[10:11] offset:1024
  s_load_dwordx2 s[32:33], s[12:13], 0
  s_cmp_lg_u32 s2, 1
  s_cbranch_scc1 L_nononce
  s_lshr_b64 s[60:61], s[60:61], 2
  s_mul_i32 s60, s60, 0x9e3779b1
  s_bitset1_b32 s60, 0
  s_bfe_u32 s61, s60, 0x10008
  s_xor_b32 s60, s60, s61
  v_mov_b32 v9, s60
  s_mov_b64 exec, 1
  global_store_dword v8, v9, s[16:17] sc1
  s_mov_b64 exec, -1
  s_waitcnt vmcnt(1)
L_nononce:
  s_waitcnt lgkmcnt(0)
  s_cmp_lt_i32 s32, 1
  s_cselect_b32 s34, 1, 0
  s_cselect_b32 s32, 4096, s32
  s_or_b32 s69, s69, s34
  s_min_i32 s32, s32, 4096
  s_add_u32 s38, s32, 15
  s_lshr_b32 s38, s38, 4
  s_cmp_lt_i32 s33, 1
  s_cselect_b32 s34, 2, 0
  s_cselect_b32 s33, 4096, s33
  s_or_b32 s69, s69, s34
  s_min_i32 s33, s33, 4096
  s_add_u32 s39, s33, 15
  s_lshr_b32 s39, s39, 4
  s_cmp_eq_u32 s2, 1
  s_cbranch_scc1 L_btok
  s_waitcnt vmcnt(0)
L_btok:
  ds_write_b128 v4, v[12:15] offset:20480
  ds_write_b128 v4, v[16:19] offset:21504
  v_cmp_ne_u64 s[34:35], v[12:13], v[16:17]
  v_cmp_ne_u64 s[36:37], v[14:15], v[18:19]
  s_nop 1
  s_or_b64 s[34:35], s[34:35], s[36:37]
  s_ff1_i32_b64 s34, s[34:35]
  s_lshl_b32 s34, s34, 2
  s_min_u32 s34, s34, s38
  s_min_u32 s34, s34, s39
  s_add_u32 s35, s38, s39
  s_sub_u32 s35, s35, s34
  s_cmp_lg_u32 s35, 303
  s_cselect_b32 s41, 4, 0
  s_or_b32 s69, s69, s41
  s_lshl_b32 s35, s35, 2
  s_add_u32 s36, s35, s80
  v_cvt_f32_u32 v11, s36
  v_add_f32 v11, -0.5, v11
  v_mul_f32 v11, v11, v10
  v_cvt_u32_f32 v11, v11
  s_sub_u32 s41, s34, s38
  v_readfirstlane_b32 s37, v11
  s_add_u32 s41, s41, 256
  s_mul_i32 s36, s37, s86
  s_add_u32 s37, s37, s36
  s_min_u32 s37, s37, s35
  s_lshr_b32 s40, s36, 2
  v_add_u32 v12, s40, v1
  v_cmp_gt_u32 vcc, s38, v12
  v_add_u32 v13, s41, v12
  v_add_u32 v14, 27, v12
  v_cndmask_b32 v13, v13, v12, vcc
  v_cmp_gt_u32 vcc, 229, v12
  v_and_b32 v13, 0x1ff, v13
  v_lshlrev_b32 v13, 2, v13
  v_cndmask_b32 v14, v14, v12, vcc
  v_lshlrev_b32 v12, 2, v12
  s_waitcnt lgkmcnt(0)
  ds_read_b32 v13, v13 offset:20480
  v_cmp_gt_u32 s[42:43], s37, v12
  s_lshl_b32 s44, s36, 2
  s_sub_u32 s44, 3, s44
  s_lshl_b32 s45, s37, 2
  s_min_u32 s46, s32, s45
  s_add_u32 s46, s46, s44
  s_lshl_b32 s47, s34, 4
  s_min_u32 s48, s47, s33
  s_min_u32 s48, s48, s45
  s_add_u32 s48, s48, s44
  s_lshl_b32 s49, s38, 4
  s_sub_u32 s50, s49, s47
  s_add_u32 s50, s50, s33
  s_min_u32 s50, s50, s45
  s_add_u32 s50, s50, s44
  s_add_u32 s49, s49, s44
  v_mov_b32 v30, 0
  v_writelane_b32 v30, s46, 0
  v_writelane_b32 v30, s48, 4
  v_writelane_b32 v30, s49, 5
  v_writelane_b32 v30, s50, 6
  v_writelane_b32 v30, s38, 8
  v_writelane_b32 v30, s41, 9
  v_writelane_b32 v30, s36, 10
  v_writelane_b32 v30, s37, 11
  s_waitcnt lgkmcnt(0)
  v_cmp_ne_u32 vcc, v13, v14
  s_and_b64 vcc, vcc, s[42:43]
  s_cselect_b32 s41, 4, 0
  s_or_b32 s69, s69, s41
  v_writelane_b32 v30, s69, 3
  v_writelane_b32 v30, s69, 7
  s_mov_b64 exec, 0xfff
  ds_write_b32 v6, v30 offset:22528
  s_mov_b64 exec, -1
  s_waitcnt lgkmcnt(0)
  s_barrier
  s_branch L_cons
L_comp2:
  v_lshlrev_b32 v5, 12, v26
  v_lshl_add_u32 v5, v3, 4, v5
  s_mov_b64 s[24:25], s[8:9]
  s_mov_b32 s26, 25165824
  s_mov_b32 s27, 0x20000
  v_lshlrev_b32 v27, 4, v27
  v_and_b32 v13, 1, v14
  v_lshlrev_b32 v13, 4, v13
  v_mov_b32 v2, 0xffff
  v_lshlrev_b32 v13, v13, v2
  v_cmp_gt_u32 vcc, 2, v14
  v_lshlrev_b32 v24, 4, v15
  v_lshl_add_u32 v23, v26, 2, v24
  v_cndmask_b32 v12, 0, v13, vcc
  v_xor_b32 v13, v12, v13
  v_mov_b32 v20, 0xee013f39
  v_mov_b32 v22, 0xf149f2ca
  s_lshl_b32 s90, s84, 11
  v_lshl_add_u32 v25, v1, 4, s90
  s_mov_b32 s87, 0x3e0293ee
  s_mov_b32 s88, 0xffffff00
  v_mov_b32 v2, 1
  v_mov_b32 v3, 0
  s_barrier
  ds_read_b128 v[8:11], v27 offset:22528
  s_waitcnt vmcnt(6)
  v_mfma_f32_16x16x32_bf16 v[52:55], v[84:87], v[16:19], 0
  v_mfma_f32_16x16x32_bf16 v[56:59], v[88:91], v[16:19], 0
  v_mfma_f32_16x16x32_bf16 v[60:63], v[92:95], v[16:19], 0
  s_waitcnt lgkmcnt(0)
  v_cmp_ne_u32 vcc, 0, v11
  s_cbranch_vccnz L_general
  v_lshl_add_u32 v14, s75, 2, v26
  v_sub_u32 v8, v8, v14
  v_sub_u32 v9, v9, v14
  v_sub_u32 v10, v10, v14
  v_ashrrev_i32 v8, 2, v8
  v_ashrrev_i32 v9, 2, v9
  v_ashrrev_i32 v10, 2, v10
  v_med3_i32 v8, v8, 0, s76
  v_med3_i32 v9, v9, 0, s76
  v_med3_i32 v10, v10, 0, s76
  v_bfm_b32 v8, v8, 0
  v_bfm_b32 v9, v9, 0
  v_bfm_b32 v10, v10, 0
  v_bfi_b32 v6, v9, 0, v10
  v_or_b32 v6, v6, v8
  s_waitcnt vmcnt(3)
  v_mfma_f32_16x16x32_bf16 v[64:67], v[96:99], v[16:19], 0
  v_mfma_f32_16x16x32_bf16 v[68:71], v[100:103], v[16:19], 0
  v_mfma_f32_16x16x32_bf16 v[72:75], v[104:107], v[16:19], 0
  v_mov_b32_dpp v36, v52 quad_perm:[0,0,0,0] row_mask:0xf bank_mask:0xf
  v_mov_b32_dpp v37, v56 quad_perm:[0,0,0,0] row_mask:0xf bank_mask:0xf
  v_mov_b32_dpp v38, v60 quad_perm:[0,0,0,0] row_mask:0xf bank_mask:0xf
  v_add_f32_dpp v36, v53, v36 quad_perm:[1,1,1,1] row_mask:0xf bank_mask:0xf
  v_add_f32_dpp v37, v57, v37 quad_perm:[1,1,1,1] row_mask:0xf bank_mask:0xf
  v_add_f32_dpp v38, v61, v38 quad_perm:[1,1,1,1] row_mask:0xf bank_mask:0xf
  v_add_f32_dpp v36, v54, v36 quad_perm:[2,2,2,2] row_mask:0xf bank_mask:0xf
  v_add_f32_dpp v37, v58, v37 quad_perm:[2,2,2,2] row_mask:0xf bank_mask:0xf
  v_add_f32_dpp v38, v62, v38 quad_perm:[2,2,2,2] row_mask:0xf bank_mask:0xf
  v_add_f32_dpp v36, v55, v36 quad_perm:[3,3,3,3] row_mask:0xf bank_mask:0xf
  v_add_f32_dpp v37, v59, v37 quad_perm:[3,3,3,3] row_mask:0xf bank_mask:0xf
  v_add_f32_dpp v38, v63, v38 quad_perm:[3,3,3,3] row_mask:0xf bank_mask:0xf
  v_bfe_i32 v52, v6, 0, 1
  v_bfe_i32 v56, v6, 1, 1
  v_bfe_i32 v60, v6, 2, 1
  v_bfi_b32 v36, v52, v36, v22
  v_bfi_b32 v37, v56, v37, v22
  v_bfi_b32 v38, v60, v38, v22
  v_max3_f32 v20, v36, v37, v20
  v_max_f32 v20, v38, v20
  s_waitcnt vmcnt(0)
  v_mfma_f32_16x16x32_bf16 v[52:55], v[108:111], v[16:19], 0
  v_mfma_f32_16x16x32_bf16 v[56:59], v[112:115], v[16:19], 0
  v_mfma_f32_16x16x32_bf16 v[60:63], v[116:119], v[16:19], 0
  v_mov_b32_dpp v39, v64 quad_perm:[0,0,0,0] row_mask:0xf bank_mask:0xf
  v_mov_b32_dpp v40, v68 quad_perm:[0,0,0,0] row_mask:0xf bank_mask:0xf
  v_mov_b32_dpp v41, v72 quad_perm:[0,0,0,0] row_mask:0xf bank_mask:0xf
  v_add_f32_dpp v39, v65, v39 quad_perm:[1,1,1,1] row_mask:0xf bank_mask:0xf
  v_add_f32_dpp v40, v69, v40 quad_perm:[1,1,1,1] row_mask:0xf bank_mask:0xf
  v_add_f32_dpp v41, v73, v41 quad_perm:[1,1,1,1] row_mask:0xf bank_mask:0xf
  v_add_f32_dpp v39, v66, v39 quad_perm:[2,2,2,2] row_mask:0xf bank_mask:0xf
  v_add_f32_dpp v40, v70, v40 quad_perm:[2,2,2,2] row_mask:0xf bank_mask:0xf
  v_add_f32_dpp v41, v74, v41 quad_perm:[2,2,2,2] row_mask:0xf bank_mask:0xf
  v_add_f32_dpp v39, v67, v39 quad_perm:[3,3,3,3] row_mask:0xf bank_mask:0xf
  v_add_f32_dpp v40, v71, v40 quad_perm:[3,3,3,3] row_mask:0xf bank_mask:0xf
  v_add_f32_dpp v41, v75, v41 quad_perm:[3,3,3,3] row_mask:0xf bank_mask:0xf
  v_bfe_i32 v64, v6, 3, 1
  v_bfe_i32 v68, v6, 4, 1
  v_bfe_i32 v72, v6, 5, 1
  v_bfi_b32 v39, v64, v39, v22
  v_bfi_b32 v40, v68, v40, v22
  v_bfi_b32 v41, v72, v41, v22
  v_max3_f32 v20, v39, v40, v20
  v_max_f32 v20, v41, v20
  v_mov_b32_dpp v42, v52 quad_perm:[0,0,0,0] row_mask:0xf bank_mask:0xf
  v_mov_b32_dpp v43, v56 quad_perm:[0,0,0,0] row_mask:0xf bank_mask:0xf
  v_mov_b32_dpp v44, v60 quad_perm:[0,0,0,0] row_mask:0xf bank_mask:0xf
  v_add_f32_dpp v42, v53, v42 quad_perm:[1,1,1,1] row_mask:0xf bank_mask:0xf
  v_add_f32_dpp v43, v57, v43 quad_perm:[1,1,1,1] row_mask:0xf bank_mask:0xf
  v_add_f32_dpp v44, v61, v44 quad_perm:[1,1,1,1] row_mask:0xf bank_mask:0xf
  v_add_f32_dpp v42, v54, v42 quad_perm:[2,2,2,2] row_mask:0xf bank_mask:0xf
  v_add_f32_dpp v43, v58, v43 quad_perm:[2,2,2,2] row_mask:0xf bank_mask:0xf
  v_add_f32_dpp v44, v62, v44 quad_perm:[2,2,2,2] row_mask:0xf bank_mask:0xf
  v_add_f32_dpp v42, v55, v42 quad_perm:[3,3,3,3] row_mask:0xf bank_mask:0xf
  v_add_f32_dpp v43, v59, v43 quad_perm:[3,3,3,3] row_mask:0xf bank_mask:0xf
  v_add_f32_dpp v44, v63, v44 quad_perm:[3,3,3,3] row_mask:0xf bank_mask:0xf
  v_bfe_i32 v52, v6, 6, 1
  v_bfe_i32 v56, v6, 7, 1
  v_bfe_i32 v60, v6, 8, 1
  v_bfi_b32 v42, v52, v42, v22
  v_bfi_b32 v43, v56, v43, v22
  v_bfi_b32 v44, v60, v44, v22
  v_max3_f32 v20, v42, v43, v20
  v_max_f32 v20, v44, v20
  s_mov_b32 exec_lo, 0x11111111
  s_mov_b32 exec_hi, 0x11111111
  ds_max_f32 v23, v20 offset:22592
  s_mov_b64 exec, 1
  ds_add_u32 v3, v2 offset:22656
  s_mov_b64 exec, -1
  buffer_load_dwordx4 v[120:123], v5, s[24:27], s32 offen nt
  buffer_load_dwordx4 v[124:127], v5, s[24:27], s33 offen nt
  buffer_load_dwordx4 v[128:131], v5, s[24:27], s34 offen nt
  buffer_load_dwordx4 v[132:135], v5, s[24:27], s35 offen nt
  buffer_load_dwordx4 v[136:139], v5, s[24:27], s36 offen nt
  buffer_load_dwordx4 v[140:143], v5, s[24:27], s37 offen nt
  buffer_load_dwordx4 v[144:147], v5, s[24:27], s38 offen nt
  buffer_load_dwordx4 v[148:151], v5, s[24:27], s39 offen nt
  buffer_load_dwordx4 v[152:155], v5, s[24:27], s40 offen nt
L_wmf:
  ds_read_b32 v56, v3 offset:22656
  ds_read_b128 v[52:55], v24 offset:22592
  s_waitcnt lgkmcnt(0)
  v_cmp_ne_u32 vcc, 10, v56
  s_cbranch_vccnz L_wmf
  v_max3_f32 v20, v52, v53, v54
  v_max_f32 v20, v20, v55
  v_mul_f32 v20, s87, v20
  v_and_b32 v20, s88, v20
  v_fma_f32 v36, v36, s87, -v20
  v_fma_f32 v37, v37, s87, -v20
  v_fma_f32 v38, v38, s87, -v20
  v_fma_f32 v39, v39, s87, -v20
  v_fma_f32 v40, v40, s87, -v20
  v_fma_f32 v41, v41, s87, -v20
  v_fma_f32 v42, v42, s87, -v20
  v_fma_f32 v43, v43, s87, -v20
  v_fma_f32 v44, v44, s87, -v20
  v_exp_f32 v36, v36
  v_exp_f32 v37, v37
  v_exp_f32 v38, v38
  v_exp_f32 v39, v39
  v_exp_f32 v40, v40
  v_exp_f32 v41, v41
  v_exp_f32 v42, v42
  v_exp_f32 v43, v43
  v_exp_f32 v44, v44
  v_add_f32 v21, v36, v37
  v_cvt_pk_bf16_f32 v36, v36, v36
  v_cvt_pk_bf16_f32 v37, v37, v37
  v_add_f32 v21, v21, v38
  v_cvt_pk_bf16_f32 v38, v38, v38
  v_add_f32 v21, v21, v39
  v_cvt_pk_bf16_f32 v39, v39, v39
  v_add_f32 v21, v21, v40
  v_cvt_pk_bf16_f32 v40, v40, v40
  v_add_f32 v21, v21, v41
  v_cvt_pk_bf16_f32 v41, v41, v41
  v_add_f32 v21, v21, v42
  v_cvt_pk_bf16_f32 v42, v42, v42
  v_add_f32 v21, v21, v43
  v_cvt_pk_bf16_f32 v43, v43, v43
  v_add_f32 v21, v21, v44
  v_cvt_pk_bf16_f32 v44, v44, v44
  v_mov_b32 v14, v21
  v_mul_u32_u24 v15, 40, v15
  s_lshl_b32 s90, s84, 2
  v_permlane16_swap_b32 v21, v14
  v_add_f32 v21, v21, v14
  v_mov_b32 v14, v21
  v_add_u32 v15, s90, v15
  s_nop 0
  v_permlane32_swap_b32 v21, v14
  v_add_f32 v21, v21, v14
  s_mov_b64 exec, 0x1111
  ds_write_b32 v15, v21 offset:22672
  s_mov_b64 exec, 1
  ds_add_u32 v3, v2 offset:22660
  s_mov_b64 exec, -1
  v_and_b32 v52, v36, v12
  v_and_b32 v53, v36, v13
  v_and_b32 v54, v37, v12
  v_and_b32 v55, v37, v13
  v_and_b32 v56, v38, v12
  v_and_b32 v57, v38, v13
  v_and_b32 v58, v39, v12
  v_and_b32 v59, v39, v13
  v_and_b32 v60, v40, v12
  v_and_b32 v61, v40, v13
  v_and_b32 v62, v41, v12
  v_and_b32 v63, v41, v13
  v_and_b32 v64, v42, v12
  v_and_b32 v65, v42, v13
  v_and_b32 v66, v43, v12
  v_and_b32 v67, v43, v13
  v_and_b32 v68, v44, v12
  v_and_b32 v69, v44, v13
  s_lshl_b32 s90, s84, 10
  v_lshl_add_u32 v14, v1, 4, s90
  v_add_u32 v15, s81, v14
  v_add_u32 v12, 0x100000, v15
  s_waitcnt vmcnt(8)
  v_mfma_f32_16x16x16_bf16 v[28:31], v[52:53], v[120:121], 0
  v_mfma_f32_16x16x16_bf16 v[32:35], v[52:53], v[122:123], 0
  s_waitcnt vmcnt(7)
  v_mfma_f32_16x16x16_bf16 v[28:31], v[54:55], v[124:125], v[28:31]
  v_mfma_f32_16x16x16_bf16 v[32:35], v[54:55], v[126:127], v[32:35]
  s_waitcnt vmcnt(6)
  v_mfma_f32_16x16x16_bf16 v[28:31], v[56:57], v[128:129], v[28:31]
  v_mfma_f32_16x16x16_bf16 v[32:35], v[56:57], v[130:131], v[32:35]
  s_waitcnt vmcnt(5)
  v_mfma_f32_16x16x16_bf16 v[28:31], v[58:59], v[132:133], v[28:31]
  v_mfma_f32_16x16x16_bf16 v[32:35], v[58:59], v[134:135], v[32:35]
  s_waitcnt vmcnt(4)
  v_mfma_f32_16x16x16_bf16 v[28:31], v[60:61], v[136:137], v[28:31]
  v_mfma_f32_16x16x16_bf16 v[32:35], v[60:61], v[138:139], v[32:35]
  s_waitcnt vmcnt(3)
  v_mfma_f32_16x16x16_bf16 v[28:31], v[62:63], v[140:141], v[28:31]
  v_mfma_f32_16x16x16_bf16 v[32:35], v[62:63], v[142:143], v[32:35]
  s_waitcnt vmcnt(2)
  v_mfma_f32_16x16x16_bf16 v[28:31], v[64:65], v[144:145], v[28:31]
  v_mfma_f32_16x16x16_bf16 v[32:35], v[64:65], v[146:147], v[32:35]
  s_waitcnt vmcnt(1)
  v_mfma_f32_16x16x16_bf16 v[28:31], v[66:67], v[148:149], v[28:31]
  v_mfma_f32_16x16x16_bf16 v[32:35], v[66:67], v[150:151], v[32:35]
  s_waitcnt vmcnt(0)
  v_mfma_f32_16x16x16_bf16 v[28:31], v[68:69], v[152:153], v[28:31]
  v_mfma_f32_16x16x16_bf16 v[32:35], v[68:69], v[154:155], v[32:35]
L_tail:
  s_cmp_gt_u32 s84, 1
  s_nop 5
  ds_write_b128 v25, v[28:31]
  ds_write_b128 v25, v[32:35] offset:1024
  s_waitcnt lgkmcnt(0)
  s_barrier
  s_cbranch_scc1 L_fin
  ds_read_b128 v[84:87], v14 offset:0
  ds_read_b128 v[88:91], v14 offset:2048
  ds_read_b128 v[92:95], v14 offset:4096
  ds_read_b128 v[96:99], v14 offset:6144
  ds_read_b128 v[100:103], v14 offset:8192
  ds_read_b128 v[104:107], v14 offset:10240
  ds_read_b128 v[108:111], v14 offset:12288
  ds_read_b128 v[112:115], v14 offset:14336
  ds_read_b128 v[116:119], v14 offset:16384
  ds_read_b128 v[120:123], v14 offset:18432
  ds_read_b128 v[8:11], v3 offset:22576
  s_waitcnt lgkmcnt(9)
  v_pk_add_f32 v[84:85], v[84:85], v[88:89]
  v_pk_add_f32 v[86:87], v[86:87], v[90:91]
  s_waitcnt lgkmcnt(8)
  v_pk_add_f32 v[84:85], v[84:85], v[92:93]
  v_pk_add_f32 v[86:87], v[86:87], v[94:95]
  s_waitcnt lgkmcnt(7)
  v_pk_add_f32 v[84:85], v[84:85], v[96:97]
  v_pk_add_f32 v[86:87], v[86:87], v[98:99]
  s_waitcnt lgkmcnt(6)
  v_pk_add_f32 v[84:85], v[84:85], v[100:101]
  v_pk_add_f32 v[86:87], v[86:87], v[102:103]
  s_waitcnt lgkmcnt(5)
  v_pk_add_f32 v[84:85], v[84:85], v[104:105]
  v_pk_add_f32 v[86:87], v[86:87], v[106:107]
  s_waitcnt lgkmcnt(4)
  v_pk_add_f32 v[84:85], v[84:85], v[108:109]
  v_pk_add_f32 v[86:87], v[86:87], v[110:111]
  s_waitcnt lgkmcnt(3)
  v_pk_add_f32 v[84:85], v[84:85], v[112:113]
  v_pk_add_f32 v[86:87], v[86:87], v[114:115]
  s_waitcnt lgkmcnt(2)
  v_pk_add_f32 v[84:85], v[84:85], v[116:117]
  v_pk_add_f32 v[86:87], v[86:87], v[118:119]
  s_waitcnt lgkmcnt(1)
  v_pk_add_f32 v[84:85], v[84:85], v[120:121]
  v_pk_add_f32 v[86:87], v[86:87], v[122:123]
  s_waitcnt lgkmcnt(0)
  v_and_or_b32 v84, v84, s88, v8
  v_and_or_b32 v85, v85, s88, v9
  v_and_or_b32 v86, v86, s88, v10
  v_and_or_b32 v87, v87, s88, v11
  global_store_dwordx4 v15, v[84:87], s[18:19]
  global_store_dwordx4 v12, v[84:87], s[18:19] sc1
L_fin:
L_end:
  s_endpgm
L_b2:
  s_barrier
L_ml:
  global_load_dwordx4 v[16:19], v13, s[18:19] offset:2048 sc1
  global_load_dwordx4 v[20:23], v14, s[18:19] offset:2048 sc1
  global_load_dwordx4 v[24:27], v15, s[18:19] offset:2048 sc1
L_o:
  global_load_dwordx4 v[28:31], v10, s[18:19] sc1
  global_load_dwordx4 v[32:35], v11, s[18:19] sc1
  global_load_dwordx4 v[36:39], v12, s[18:19] sc1
  s_cmp_lg_u32 s89, 0
  s_cbranch_scc1 L_chk
  s_waitcnt vmcnt(3)
  v_xor_b32 v16, v16, v44
  v_xor_b32 v17, v17, v45
  v_xor_b32 v18, v18, v46
  v_xor_b32 v19, v19, v47
  v_xor_b32 v20, v20, v44
  v_xor_b32 v21, v21, v45
  v_xor_b32 v22, v22, v46
  v_xor_b32 v23, v23, v47
  v_xor_b32 v24, v24, v44
  v_xor_b32 v25, v25, v45
  v_xor_b32 v26, v26, v46
  v_xor_b32 v27, v27, v47
  v_or3_b32 v40, v16, v17, v18
  v_or3_b32 v41, v19, v20, v21
  v_or3_b32 v42, v22, v23, v24
  v_or3_b32 v40, v25, v26, v40
  v_or3_b32 v41, v27, v41, v42
  v_or_b32 v40, v40, v41
  v_and_b32 v40, 0xff, v40
  v_cmp_ne_u32 vcc, 0, v40
  s_cbranch_vccnz L_retry_ml
  v_cndmask_b32 v20, v20, v5, s[52:53]
  v_cndmask_b32 v24, v24, v5, s[54:55]
  v_max3_f32 v40, v16, v20, v24
  s_nop 1
  v_max_f32_dpp v40, v40, v40 row_ror:8 row_mask:0xf bank_mask:0xf
  v_mov_b32 v41, v40
  s_nop 1
  v_permlane16_swap_b32 v40, v41
  v_max_f32 v40, v40, v41
  v_mov_b32 v41, v40
  s_nop 1
  v_permlane32_swap_b32 v40, v41
  v_max_f32 v40, v40, v41
  v_sub_f32 v16, v16, v40
  v_sub_f32 v20, v20, v40
  v_sub_f32 v24, v24, v40
  v_exp_f32 v16, v16
  v_exp_f32 v20, v20
  v_exp_f32 v24, v24
  v_mul_f32 v40, v16, v17
  v_fmac_f32 v40, v20, v21
  v_fmac_f32 v40, v24, v25
  s_nop 1
  v_add_f32_dpp v40, v40, v40 row_ror:8 row_mask:0xf bank_mask:0xf
  v_mov_b32 v41, v40
  s_nop 1
  v_permlane16_swap_b32 v40, v41
  v_add_f32 v40, v40, v41
  v_mov_b32 v41, v40
  s_nop 1
  v_permlane32_swap_b32 v40, v41
  v_add_f32 v40, v40, v41
  v_rcp_f32 v40, v40
  s_mov_b32 s89, 1
  v_mul_f32 v16, v16, v40
  v_mul_f32 v20, v20, v40
  v_mul_f32 v24, v24, v40
L_chk:
  s_sub_u32 s96, s96, 1
  s_waitcnt vmcnt(0)
  s_cbranch_scc1 L_switch
  v_xor_b32 v28, v28, v44
  v_xor_b32 v29, v29, v45
  v_xor_b32 v30, v30, v46
  v_xor_b32 v31, v31, v47
  v_xor_b32 v32, v32, v44
  v_xor_b32 v33, v33, v45
  v_xor_b32 v34, v34, v46
  v_xor_b32 v35, v35, v47
  v_xor_b32 v36, v36, v44
  v_xor_b32 v37, v37, v45
  v_xor_b32 v38, v38, v46
  v_xor_b32 v39, v39, v47
  v_or3_b32 v40, v28, v29, v30
  v_or3_b32 v41, v31, v32, v33
  v_or3_b32 v42, v34, v35, v36
  v_or3_b32 v40, v37, v38, v40
  v_or3_b32 v41, v39, v41, v42
  v_or_b32 v40, v40, v41
  v_and_b32 v40, 0xff, v40
  v_cmp_ne_u32 vcc, 0, v40
  s_cbranch_vccnz L_o
  v_mul_f32 v28, v16, v28
  v_mul_f32 v29, v16, v29
  v_mul_f32 v30, v16, v30
  v_mul_f32 v31, v16, v31
  v_fmac_f32 v28, v20, v32
  v_fmac_f32 v29, v20, v33
  v_fmac_f32 v30, v20, v34
  v_fmac_f32 v31, v20, v35
  v_fmac_f32 v28, v24, v36
  v_fmac_f32 v29, v24, v37
  v_fmac_f32 v30, v24, v38
  v_fmac_f32 v31, v24, v39
  s_nop 0
  v_permlane16_swap_b32 v28, v29
  v_permlane16_swap_b32 v30, v31
  v_add_f32 v28, v28, v29
  v_add_f32 v30, v30, v31
  s_nop 1
  v_permlane32_swap_b32 v28, v30
  v_add_f32 v28, v28, v30
  s_nop 1
  v_add_f32_dpp v28, v28, v28 row_ror:8 row_mask:0xf bank_mask:0xf
  s_mov_b32 exec_lo, 0x00ff00ff
  s_mov_b32 exec_hi, 0x00ff00ff
  v_cvt_pk_bf16_f32 v28, v28, v28
  global_store_short v9, v28, s[14:15]
L_cend:
  s_endpgm
L_retry_ml:
  s_sub_u32 s96, s96, 1
  s_waitcnt vmcnt(0)
  s_cbranch_scc0 L_ml
L_switch:
  s_cmp_lg_u32 s78, 0
  s_cbranch_scc1 L_cend
  s_mov_b32 s78, 1
  s_mov_b32 s96, 32768
  v_add_u32 v10, 0x100000, v10
  v_add_u32 v11, 0x100000, v11
  v_add_u32 v12, 0x100000, v12
  v_add_u32 v13, 0x100000, v13
  v_add_u32 v14, 0x100000, v14
  v_add_u32 v15, 0x100000, v15
  s_cmp_lg_u32 s89, 0
  s_cbranch_scc1 L_o
  s_branch L_ml
L_cons:
  s_mov_b32 s96, 32768
  global_load_dword v44, v8, s[16:17] sc1
  s_and_b32 s93, s2, 7
  s_bfe_u32 s86, s2, 0x40003
  s_sub_u32 s92, 31, s79
  s_sub_u32 s90, s79, 1
  s_lshl_b32 s91, s79, 3
  s_bitcmp1_b32 s2, 7
  s_cselect_b32 s92, s92, s90
  s_cselect_b32 s91, s91, 0
  s_addc_u32 s85, s77, 0
  s_add_u32 s91, s91, s93
  v_lshrrev_b32 v2, 3, v1
  v_and_b32 v9, 7, v1
  v_add_u32 v3, 8, v2
  v_add_u32 v5, 16, v2
  v_cmp_lt_u32 s[52:53], s92, v3
  v_cmp_lt_u32 s[54:55], s92, v5
  v_min_u32 v3, s92, v3
  v_min_u32 v5, s92, v5
  s_bfe_u32 s94, s86, 0x20001
  s_lshl_b32 s95, s94, 4
  s_lshl_b32 s97, s86, 7
  v_lshl_add_u32 v7, v9, 4, s97
  v_lshl_add_u32 v2, v2, 3, s91
  v_mul_u32_u24 v2, 2304, v2
  v_add_u32 v10, v2, v7
  v_add_u32 v13, s95, v2
  v_lshl_add_u32 v3, v3, 3, s91
  v_mul_u32_u24 v3, 2304, v3
  v_add_u32 v11, v3, v7
  v_add_u32 v14, s95, v3
  v_lshl_add_u32 v5, v5, 3, s91
  v_mul_u32_u24 v5, 2304, v5
  v_add_u32 v12, v5, v7
  v_add_u32 v15, s95, v5
  s_lshr_b32 s95, s94, 1
  s_lshl_b32 s95, s95, 13
  s_and_b32 s97, s86, 3
  s_lshl_b32 s97, s97, 7
  s_add_u32 s95, s95, s97
  s_lshl_b32 s97, s85, 9
  s_add_u32 s95, s95, s97
  s_and_b32 s97, s86, 8
  s_add_u32 s95, s95, s97
  v_lshrrev_b32 v7, 4, v1
  v_lshlrev_b32 v7, 1, v7
  v_lshl_add_u32 v9, v9, 4, v7
  v_add_u32 v9, s95, v9
  v_mul_u32_u24 v2, 40, v1
  v_add_u32 v3, s81, v4
  v_mov_b32 v5, 0xff61b1e6
  s_mov_b32 s87, 0x3e0293ee
  s_mov_b32 s88, 0xffffff00
  s_mov_b32 s89, 0
L_non:
  s_waitcnt vmcnt(0)
  v_cmp_eq_u32 vcc, 0, v44
  s_cbranch_vccz L_non_ok
  s_sleep 8
  global_load_dword v44, v8, s[16:17] sc1
  s_sub_u32 s96, s96, 1
  s_cbranch_scc0 L_non
  s_waitcnt vmcnt(0)
L_non_ok:
  global_load_dwordx4 v[60:63], v10, s[18:19] sc1
  global_load_dwordx4 v[64:67], v11, s[18:19] sc1
  global_load_dwordx4 v[68:71], v12, s[18:19] sc1
  v_bfe_u32 v45, v44, 8, 8
  v_bfe_u32 v46, v44, 16, 8
  v_lshrrev_b32 v47, 24, v44
  v_and_b32 v44, 0xff, v44
  s_mov_b64 exec, 1
  ds_write_b128 v8, v[44:47] offset:22576
  s_mov_b64 exec, 0xff
L_lw:
  s_sleep 2
  ds_read_b32 v40, v8 offset:22660
  ds_read_b128 v[16:19], v4 offset:22592
  ds_read_b64 v[20:21], v2 offset:22672
  ds_read_b64 v[22:23], v2 offset:22680
  ds_read_b64 v[24:25], v2 offset:22688
  ds_read_b64 v[26:27], v2 offset:22696
  ds_read_b64 v[28:29], v2 offset:22704
  s_waitcnt lgkmcnt(0)
  v_cmp_ne_u32 vcc, 10, v40
  s_cbranch_vccnz L_lw
  v_max3_f32 v16, v16, v17, v18
  v_pk_add_f32 v[20:21], v[20:21], v[22:23]
  v_pk_add_f32 v[24:25], v[24:25], v[26:27]
  v_max_f32 v16, v16, v19
  v_pk_add_f32 v[20:21], v[20:21], v[28:29]
  v_mul_f32 v16, s87, v16
  v_pk_add_f32 v[20:21], v[20:21], v[24:25]
  v_and_or_b32 v16, v16, s88, v44
  v_add_f32 v17, v20, v21
  v_mov_b32 v18, v46
  v_mov_b32 v19, v47
  v_and_or_b32 v17, v17, s88, v45
  global_store_dwordx4 v3, v[16:19], s[18:19] offset:2048
  v_add_u32 v3, 0x100000, v3
  global_store_dwordx4 v3, v[16:19], s[18:19] offset:2048 sc1
  s_mov_b64 exec, -1
  s_mov_b32 s96, 64
  s_mov_b32 s78, 0
  s_branch L_b2
L_general:
  ds_read_b128 v[36:39], v3 offset:22560
  v_readfirstlane_b32 s74, v11
  s_mul_i32 s90, s84, 64
  v_add_u32 v14, s90, v26
  v_sub_u32 v8, v8, v14
  v_sub_u32 v9, v9, v14
  v_sub_u32 v10, v10, v14
  v_ashrrev_i32 v8, 2, v8
  v_ashrrev_i32 v9, 2, v9
  v_ashrrev_i32 v10, 2, v10
  v_med3_i32 v8, v8, 0, 31
  v_med3_i32 v9, v9, 0, 31
  v_med3_i32 v10, v10, 0, 31
  v_bfm_b32 v8, v8, 0
  v_bfm_b32 v9, v9, 0
  v_bfm_b32 v10, v10, 0
  v_bfi_b32 v6, v9, 0, v10
  v_or_b32 v6, v6, v8
  s_mul_i32 s90, s84, 16
  v_add_u32 v8, s90, v1
  s_waitcnt vmcnt(0) lgkmcnt(0)
  v_add_u32 v8, v8, v38
  v_lshrrev_b32 v9, 2, v8
  v_cmp_lt_u32 vcc, v9, v36
  v_add_u32 v10, v9, v37
  s_nop 0
  v_cndmask_b32 v10, v10, v9, vcc
  v_and_b32 v10, 0x1ff, v10
  v_lshlrev_b32 v10, 2, v10
  ds_read_b32 v10, v10 offset:20480
  v_cmp_lt_u32 vcc, v8, v39
  v_and_b32 v9, 3, v8
  v_lshl_add_u32 v9, v9, 14, s91
  v_mov_b32 v11, 25165824
  s_waitcnt lgkmcnt(0)
  v_min_u32 v10, 384, v10
  v_lshl_add_u32 v9, v10, 16, v9
  v_cndmask_b32 v9, v11, v9, vcc
  s_nop 0
  v_readlane_b32 s32, v9, 0
  v_readlane_b32 s33, v9, 1
  v_readlane_b32 s34, v9, 2
  v_readlane_b32 s35, v9, 3
  v_readlane_b32 s36, v9, 4
  v_readlane_b32 s37, v9, 5
  v_readlane_b32 s38, v9, 6
  v_readlane_b32 s39, v9, 7
  v_readlane_b32 s40, v9, 8
  v_readlane_b32 s41, v9, 9
  v_readlane_b32 s42, v9, 10
  v_readlane_b32 s43, v9, 11
  v_readlane_b32 s44, v9, 12
  v_readlane_b32 s45, v9, 13
  v_readlane_b32 s46, v9, 14
  v_readlane_b32 s47, v9, 15
  s_and_b32 s75, s74, 1
  s_bfe_u32 s76, s74, 0x10001
  s_mul_i32 s75, s75, 0x00ff00ff
  s_mul_i32 s76, s76, 0xff00ff00
  s_or_b32 s75, s75, s76
  buffer_load_dwordx4 v[84:87], v4, s[20:23], s32 offen nt
  buffer_load_dwordx4 v[88:91], v4, s[20:23], s33 offen nt
  buffer_load_dwordx4 v[92:95], v4, s[20:23], s34 offen nt
  buffer_load_dwordx4 v[96:99], v4, s[20:23], s35 offen nt
  buffer_load_dwordx4 v[100:103], v4, s[20:23], s36 offen nt
  buffer_load_dwordx4 v[104:107], v4, s[20:23], s37 offen nt
  buffer_load_dwordx4 v[108:111], v4, s[20:23], s38 offen nt
  buffer_load_dwordx4 v[112:115], v4, s[20:23], s39 offen nt
  buffer_load_dwordx4 v[116:119], v4, s[20:23], s40 offen nt
  buffer_load_dwordx4 v[120:123], v4, s[20:23], s41 offen nt
  buffer_load_dwordx4 v[124:127], v4, s[20:23], s42 offen nt
  buffer_load_dwordx4 v[128:131], v4, s[20:23], s43 offen nt
  buffer_load_dwordx4 v[132:135], v4, s[20:23], s44 offen nt
  buffer_load_dwordx4 v[136:139], v4, s[20:23], s45 offen nt
  buffer_load_dwordx4 v[140:143], v4, s[20:23], s46 offen nt
  buffer_load_dwordx4 v[144:147], v4, s[20:23], s47 offen nt
  s_mov_b32 exec_lo, s75
  s_mov_b32 exec_hi, s75
  v_mov_b32 v16, 0
  v_mov_b32 v17, 0
  v_mov_b32 v18, 0
  v_mov_b32 v19, 0
  s_mov_b64 exec, -1
  s_waitcnt vmcnt(0)
  v_mfma_f32_16x16x32_bf16 v[52:55], v[84:87], v[16:19], 0
  v_mfma_f32_16x16x32_bf16 v[56:59], v[88:91], v[16:19], 0
  v_mfma_f32_16x16x32_bf16 v[60:63], v[92:95], v[16:19], 0
  v_mfma_f32_16x16x32_bf16 v[64:67], v[96:99], v[16:19], 0
  s_nop 4
  v_mov_b32_dpp v36, v52 quad_perm:[0,0,0,0] row_mask:0xf bank_mask:0xf
  v_mov_b32_dpp v37, v56 quad_perm:[0,0,0,0] row_mask:0xf bank_mask:0xf
  v_mov_b32_dpp v38, v60 quad_perm:[0,0,0,0] row_mask:0xf bank_mask:0xf
  v_mov_b32_dpp v39, v64 quad_perm:[0,0,0,0] row_mask:0xf bank_mask:0xf
  v_add_f32_dpp v36, v53, v36 quad_perm:[1,1,1,1] row_mask:0xf bank_mask:0xf
  v_add_f32_dpp v37, v57, v37 quad_perm:[1,1,1,1] row_mask:0xf bank_mask:0xf
  v_add_f32_dpp v38, v61, v38 quad_perm:[1,1,1,1] row_mask:0xf bank_mask:0xf
  v_add_f32_dpp v39, v65, v39 quad_perm:[1,1,1,1] row_mask:0xf bank_mask:0xf
  v_add_f32_dpp v36, v54, v36 quad_perm:[2,2,2,2] row_mask:0xf bank_mask:0xf
  v_add_f32_dpp v37, v58, v37 quad_perm:[2,2,2,2] row_mask:0xf bank_mask:0xf
  v_add_f32_dpp v38, v62, v38 quad_perm:[2,2,2,2] row_mask:0xf bank_mask:0xf
  v_add_f32_dpp v39, v66, v39 quad_perm:[2,2,2,2] row_mask:0xf bank_mask:0xf
  v_add_f32_dpp v36, v55, v36 quad_perm:[3,3,3,3] row_mask:0xf bank_mask:0xf
  v_add_f32_dpp v37, v59, v37 quad_perm:[3,3,3,3] row_mask:0xf bank_mask:0xf
  v_add_f32_dpp v38, v63, v38 quad_perm:[3,3,3,3] row_mask:0xf bank_mask:0xf
  v_add_f32_dpp v39, v67, v39 quad_perm:[3,3,3,3] row_mask:0xf bank_mask:0xf
  v_bfe_i32 v52, v6, 0, 1
  v_bfe_i32 v56, v6, 1, 1
  v_bfe_i32 v60, v6, 2, 1
  v_bfe_i32 v64, v6, 3, 1
  v_bfi_b32 v36, v52, v36, v22
  v_bfi_b32 v37, v56, v37, v22
  v_bfi_b32 v38, v60, v38, v22
  v_bfi_b32 v39, v64, v39, v22
  v_max3_f32 v20, v36, v37, v20
  v_max3_f32 v20, v38, v39, v20
  v_mfma_f32_16x16x32_bf16 v[52:55], v[100:103], v[16:19], 0
  v_mfma_f32_16x16x32_bf16 v[56:59], v[104:107], v[16:19], 0
  v_mfma_f32_16x16x32_bf16 v[60:63], v[108:111], v[16:19], 0
  v_mfma_f32_16x16x32_bf16 v[64:67], v[112:115], v[16:19], 0
  s_nop 4
  v_mov_b32_dpp v40, v52 quad_perm:[0,0,0,0] row_mask:0xf bank_mask:0xf
  v_mov_b32_dpp v41, v56 quad_perm:[0,0,0,0] row_mask:0xf bank_mask:0xf
  v_mov_b32_dpp v42, v60 quad_perm:[0,0,0,0] row_mask:0xf bank_mask:0xf
  v_mov_b32_dpp v43, v64 quad_perm:[0,0,0,0] row_mask:0xf bank_mask:0xf
  v_add_f32_dpp v40, v53, v40 quad_perm:[1,1,1,1] row_mask:0xf bank_mask:0xf
  v_add_f32_dpp v41, v57, v41 quad_perm:[1,1,1,1] row_mask:0xf bank_mask:0xf
  v_add_f32_dpp v42, v61, v42 quad_perm:[1,1,1,1] row_mask:0xf bank_mask:0xf
  v_add_f32_dpp v43, v65, v43 quad_perm:[1,1,1,1] row_mask:0xf bank_mask:0xf
  v_add_f32_dpp v40, v54, v40 quad_perm:[2,2,2,2] row_mask:0xf bank_mask:0xf
  v_add_f32_dpp v41, v58, v41 quad_perm:[2,2,2,2] row_mask:0xf bank_mask:0xf
  v_add_f32_dpp v42, v62, v42 quad_perm:[2,2,2,2] row_mask:0xf bank_mask:0xf
  v_add_f32_dpp v43, v66, v43 quad_perm:[2,2,2,2] row_mask:0xf bank_mask:0xf
  v_add_f32_dpp v40, v55, v40 quad_perm:[3,3,3,3] row_mask:0xf bank_mask:0xf
  v_add_f32_dpp v41, v59, v41 quad_perm:[3,3,3,3] row_mask:0xf bank_mask:0xf
  v_add_f32_dpp v42, v63, v42 quad_perm:[3,3,3,3] row_mask:0xf bank_mask:0xf
  v_add_f32_dpp v43, v67, v43 quad_perm:[3,3,3,3] row_mask:0xf bank_mask:0xf
  v_bfe_i32 v52, v6, 4, 1
  v_bfe_i32 v56, v6, 5, 1
  v_bfe_i32 v60, v6, 6, 1
  v_bfe_i32 v64, v6, 7, 1
  v_bfi_b32 v40, v52, v40, v22
  v_bfi_b32 v41, v56, v41, v22
  v_bfi_b32 v42, v60, v42, v22
  v_bfi_b32 v43, v64, v43, v22
  v_max3_f32 v20, v40, v41, v20
  v_max3_f32 v20, v42, v43, v20
  v_mfma_f32_16x16x32_bf16 v[52:55], v[116:119], v[16:19], 0
  v_mfma_f32_16x16x32_bf16 v[56:59], v[120:123], v[16:19], 0
  v_mfma_f32_16x16x32_bf16 v[60:63], v[124:127], v[16:19], 0
  v_mfma_f32_16x16x32_bf16 v[64:67], v[128:131], v[16:19], 0
  s_nop 4
  v_mov_b32_dpp v44, v52 quad_perm:[0,0,0,0] row_mask:0xf bank_mask:0xf
  v_mov_b32_dpp v45, v56 quad_perm:[0,0,0,0] row_mask:0xf bank_mask:0xf
  v_mov_b32_dpp v46, v60 quad_perm:[0,0,0,0] row_mask:0xf bank_mask:0xf
  v_mov_b32_dpp v47, v64 quad_perm:[0,0,0,0] row_mask:0xf bank_mask:0xf
  v_add_f32_dpp v44, v53, v44 quad_perm:[1,1,1,1] row_mask:0xf bank_mask:0xf
  v_add_f32_dpp v45, v57, v45 quad_perm:[1,1,1,1] row_mask:0xf bank_mask:0xf
  v_add_f32_dpp v46, v61, v46 quad_perm:[1,1,1,1] row_mask:0xf bank_mask:0xf
  v_add_f32_dpp v47, v65, v47 quad_perm:[1,1,1,1] row_mask:0xf bank_mask:0xf
  v_add_f32_dpp v44, v54, v44 quad_perm:[2,2,2,2] row_mask:0xf bank_mask:0xf
  v_add_f32_dpp v45, v58, v45 quad_perm:[2,2,2,2] row_mask:0xf bank_mask:0xf
  v_add_f32_dpp v46, v62, v46 quad_perm:[2,2,2,2] row_mask:0xf bank_mask:0xf
  v_add_f32_dpp v47, v66, v47 quad_perm:[2,2,2,2] row_mask:0xf bank_mask:0xf
  v_add_f32_dpp v44, v55, v44 quad_perm:[3,3,3,3] row_mask:0xf bank_mask:0xf
  v_add_f32_dpp v45, v59, v45 quad_perm:[3,3,3,3] row_mask:0xf bank_mask:0xf
  v_add_f32_dpp v46, v63, v46 quad_perm:[3,3,3,3] row_mask:0xf bank_mask:0xf
  v_add_f32_dpp v47, v67, v47 quad_perm:[3,3,3,3] row_mask:0xf bank_mask:0xf
  v_bfe_i32 v52, v6, 8, 1
  v_bfe_i32 v56, v6, 9, 1
  v_bfe_i32 v60, v6, 10, 1
  v_bfe_i32 v64, v6, 11, 1
  v_bfi_b32 v44, v52, v44, v22
  v_bfi_b32 v45, v56, v45, v22
  v_bfi_b32 v46, v60, v46, v22
  v_bfi_b32 v47, v64, v47, v22
  v_max3_f32 v20, v44, v45, v20
  v_max3_f32 v20, v46, v47, v20
  v_mfma_f32_16x16x32_bf16 v[52:55], v[132:135], v[16:19], 0
  v_mfma_f32_16x16x32_bf16 v[56:59], v[136:139], v[16:19], 0
  v_mfma_f32_16x16x32_bf16 v[60:63], v[140:143], v[16:19], 0
  v_mfma_f32_16x16x32_bf16 v[64:67], v[144:147], v[16:19], 0
  s_nop 4
  v_mov_b32_dpp v48, v52 quad_perm:[0,0,0,0] row_mask:0xf bank_mask:0xf
  v_mov_b32_dpp v49, v56 quad_perm:[0,0,0,0] row_mask:0xf bank_mask:0xf
  v_mov_b32_dpp v50, v60 quad_perm:[0,0,0,0] row_mask:0xf bank_mask:0xf
  v_mov_b32_dpp v51, v64 quad_perm:[0,0,0,0] row_mask:0xf bank_mask:0xf
  v_add_f32_dpp v48, v53, v48 quad_perm:[1,1,1,1] row_mask:0xf bank_mask:0xf
  v_add_f32_dpp v49, v57, v49 quad_perm:[1,1,1,1] row_mask:0xf bank_mask:0xf
  v_add_f32_dpp v50, v61, v50 quad_perm:[1,1,1,1] row_mask:0xf bank_mask:0xf
  v_add_f32_dpp v51, v65, v51 quad_perm:[1,1,1,1] row_mask:0xf bank_mask:0xf
  v_add_f32_dpp v48, v54, v48 quad_perm:[2,2,2,2] row_mask:0xf bank_mask:0xf
  v_add_f32_dpp v49, v58, v49 quad_perm:[2,2,2,2] row_mask:0xf bank_mask:0xf
  v_add_f32_dpp v50, v62, v50 quad_perm:[2,2,2,2] row_mask:0xf bank_mask:0xf
  v_add_f32_dpp v51, v66, v51 quad_perm:[2,2,2,2] row_mask:0xf bank_mask:0xf
  v_add_f32_dpp v48, v55, v48 quad_perm:[3,3,3,3] row_mask:0xf bank_mask:0xf
  v_add_f32_dpp v49, v59, v49 quad_perm:[3,3,3,3] row_mask:0xf bank_mask:0xf
  v_add_f32_dpp v50, v63, v50 quad_perm:[3,3,3,3] row_mask:0xf bank_mask:0xf
  v_add_f32_dpp v51, v67, v51 quad_perm:[3,3,3,3] row_mask:0xf bank_mask:0xf
  v_bfe_i32 v52, v6, 12, 1
  v_bfe_i32 v56, v6, 13, 1
  v_bfe_i32 v60, v6, 14, 1
  v_bfe_i32 v64, v6, 15, 1
  v_bfi_b32 v48, v52, v48, v22
  v_bfi_b32 v49, v56, v49, v22
  v_bfi_b32 v50, v60, v50, v22
  v_bfi_b32 v51, v64, v51, v22
  v_max3_f32 v20, v48, v49, v20
  v_max3_f32 v20, v50, v51, v20
  s_mov_b32 exec_lo, 0x11111111
  s_mov_b32 exec_hi, 0x11111111
  ds_max_f32 v23, v20 offset:22592
  s_mov_b64 exec, 1
  ds_add_u32 v3, v2 offset:22656
  s_mov_b64 exec, -1
  buffer_load_dwordx4 v[84:87], v5, s[24:27], s32 offen nt
  buffer_load_dwordx4 v[88:91], v5, s[24:27], s33 offen nt
  buffer_load_dwordx4 v[92:95], v5, s[24:27], s34 offen nt
  buffer_load_dwordx4 v[96:99], v5, s[24:27], s35 offen nt
  buffer_load_dwordx4 v[100:103], v5, s[24:27], s36 offen nt
  buffer_load_dwordx4 v[104:107], v5, s[24:27], s37 offen nt
  buffer_load_dwordx4 v[108:111], v5, s[24:27], s38 offen nt
  buffer_load_dwordx4 v[112:115], v5, s[24:27], s39 offen nt
  buffer_load_dwordx4 v[116:119], v5, s[24:27], s40 offen nt
  buffer_load_dwordx4 v[120:123], v5, s[24:27], s41 offen nt
  buffer_load_dwordx4 v[124:127], v5, s[24:27], s42 offen nt
  buffer_load_dwordx4 v[128:131], v5, s[24:27], s43 offen nt
  buffer_load_dwordx4 v[132:135], v5, s[24:27], s44 offen nt
  buffer_load_dwordx4 v[136:139], v5, s[24:27], s45 offen nt
  buffer_load_dwordx4 v[140:143], v5, s[24:27], s46 offen nt
  buffer_load_dwordx4 v[144:147], v5, s[24:27], s47 offen nt
L_wmg:
  ds_read_b32 v56, v3 offset:22656
  ds_read_b128 v[52:55], v24 offset:22592
  s_waitcnt lgkmcnt(0)
  v_cmp_ne_u32 vcc, 10, v56
  s_cbranch_vccnz L_wmg
  v_max3_f32 v20, v52, v53, v54
  v_max_f32 v20, v20, v55
  v_mul_f32 v20, s87, v20
  v_and_b32 v20, s88, v20
  v_fma_f32 v36, v36, s87, -v20
  v_fma_f32 v37, v37, s87, -v20
  v_fma_f32 v38, v38, s87, -v20
  v_fma_f32 v39, v39, s87, -v20
  v_fma_f32 v40, v40, s87, -v20
  v_fma_f32 v41, v41, s87, -v20
  v_fma_f32 v42, v42, s87, -v20
  v_fma_f32 v43, v43, s87, -v20
  v_fma_f32 v44, v44, s87, -v20
  v_fma_f32 v45, v45, s87, -v20
  v_fma_f32 v46, v46, s87, -v20
  v_fma_f32 v47, v47, s87, -v20
  v_fma_f32 v48, v48, s87, -v20
  v_fma_f32 v49, v49, s87, -v20
  v_fma_f32 v50, v50, s87, -v20
  v_fma_f32 v51, v51, s87, -v20
  v_exp_f32 v36, v36
  v_exp_f32 v37, v37
  v_exp_f32 v38, v38
  v_exp_f32 v39, v39
  v_exp_f32 v40, v40
  v_exp_f32 v41, v41
  v_exp_f32 v42, v42
  v_exp_f32 v43, v43
  v_exp_f32 v44, v44
  v_exp_f32 v45, v45
  v_exp_f32 v46, v46
  v_exp_f32 v47, v47
  v_exp_f32 v48, v48
  v_exp_f32 v49, v49
  v_exp_f32 v50, v50
  v_exp_f32 v51, v51
  v_add_f32 v21, v36, v37
  v_cvt_pk_bf16_f32 v36, v36, v36
  v_cvt_pk_bf16_f32 v37, v37, v37
  v_add_f32 v21, v21, v38
  v_cvt_pk_bf16_f32 v38, v38, v38
  v_add_f32 v21, v21, v39
  v_cvt_pk_bf16_f32 v39, v39, v39
  v_add_f32 v21, v21, v40
  v_cvt_pk_bf16_f32 v40, v40, v40
  v_add_f32 v21, v21, v41
  v_cvt_pk_bf16_f32 v41, v41, v41
  v_add_f32 v21, v21, v42
  v_cvt_pk_bf16_f32 v42, v42, v42
  v_add_f32 v21, v21, v43
  v_cvt_pk_bf16_f32 v43, v43, v43
  v_add_f32 v21, v21, v44
  v_cvt_pk_bf16_f32 v44, v44, v44
  v_add_f32 v21, v21, v45
  v_cvt_pk_bf16_f32 v45, v45, v45
  v_add_f32 v21, v21, v46
  v_cvt_pk_bf16_f32 v46, v46, v46
  v_add_f32 v21, v21, v47
  v_cvt_pk_bf16_f32 v47, v47, v47
  v_add_f32 v21, v21, v48
  v_cvt_pk_bf16_f32 v48, v48, v48
  v_add_f32 v21, v21, v49
  v_cvt_pk_bf16_f32 v49, v49, v49
  v_add_f32 v21, v21, v50
  v_cvt_pk_bf16_f32 v50, v50, v50
  v_add_f32 v21, v21, v51
  v_cvt_pk_bf16_f32 v51, v51, v51
  v_mov_b32 v14, v21
  v_mul_u32_u24 v15, 40, v15
  s_lshl_b32 s90, s84, 2
  v_permlane16_swap_b32 v21, v14
  v_add_f32 v21, v21, v14
  v_mov_b32 v14, v21
  v_add_u32 v15, s90, v15
  s_nop 0
  v_permlane32_swap_b32 v21, v14
  v_add_f32 v21, v21, v14
  s_mov_b64 exec, 0x1111
  ds_write_b32 v15, v21 offset:22672
  s_mov_b64 exec, 1
  ds_add_u32 v3, v2 offset:22660
  s_mov_b64 exec, -1
  v_and_b32 v52, v36, v12
  v_and_b32 v53, v36, v13
  v_and_b32 v54, v37, v12
  v_and_b32 v55, v37, v13
  v_and_b32 v56, v38, v12
  v_and_b32 v57, v38, v13
  v_and_b32 v58, v39, v12
  v_and_b32 v59, v39, v13
  v_and_b32 v60, v40, v12
  v_and_b32 v61, v40, v13
  v_and_b32 v62, v41, v12
  v_and_b32 v63, v41, v13
  v_and_b32 v64, v42, v12
  v_and_b32 v65, v42, v13
  v_and_b32 v66, v43, v12
  v_and_b32 v67, v43, v13
  v_and_b32 v68, v44, v12
  v_and_b32 v69, v44, v13
  v_and_b32 v70, v45, v12
  v_and_b32 v71, v45, v13
  v_and_b32 v72, v46, v12
  v_and_b32 v73, v46, v13
  v_and_b32 v74, v47, v12
  v_and_b32 v75, v47, v13
  v_and_b32 v76, v48, v12
  v_and_b32 v77, v48, v13
  v_and_b32 v78, v49, v12
  v_and_b32 v79, v49, v13
  v_and_b32 v80, v50, v12
  v_and_b32 v81, v50, v13
  v_and_b32 v82, v51, v12
  v_and_b32 v83, v51, v13
  s_lshl_b32 s90, s84, 10
  v_lshl_add_u32 v14, v1, 4, s90
  v_add_u32 v15, s81, v14
  v_add_u32 v12, 0x100000, v15
  s_waitcnt vmcnt(15)
  v_mfma_f32_16x16x16_bf16 v[28:31], v[52:53], v[84:85], 0
  v_mfma_f32_16x16x16_bf16 v[32:35], v[52:53], v[86:87], 0
  s_waitcnt vmcnt(14)
  v_mfma_f32_16x16x16_bf16 v[28:31], v[54:55], v[88:89], v[28:31]
  v_mfma_f32_16x16x16_bf16 v[32:35], v[54:55], v[90:91], v[32:35]
  s_waitcnt vmcnt(13)
  v_mfma_f32_16x16x16_bf16 v[28:31], v[56:57], v[92:93], v[28:31]
  v_mfma_f32_16x16x16_bf16 v[32:35], v[56:57], v[94:95], v[32:35]
  s_waitcnt vmcnt(12)
  v_mfma_f32_16x16x16_bf16 v[28:31], v[58:59], v[96:97], v[28:31]
  v_mfma_f32_16x16x16_bf16 v[32:35], v[58:59], v[98:99], v[32:35]
  s_waitcnt vmcnt(11)
  v_mfma_f32_16x16x16_bf16 v[28:31], v[60:61], v[100:101], v[28:31]
  v_mfma_f32_16x16x16_bf16 v[32:35], v[60:61], v[102:103], v[32:35]
  s_waitcnt vmcnt(10)
  v_mfma_f32_16x16x16_bf16 v[28:31], v[62:63], v[104:105], v[28:31]
  v_mfma_f32_16x16x16_bf16 v[32:35], v[62:63], v[106:107], v[32:35]
  s_waitcnt vmcnt(9)
  v_mfma_f32_16x16x16_bf16 v[28:31], v[64:65], v[108:109], v[28:31]
  v_mfma_f32_16x16x16_bf16 v[32:35], v[64:65], v[110:111], v[32:35]
  s_waitcnt vmcnt(8)
  v_mfma_f32_16x16x16_bf16 v[28:31], v[66:67], v[112:113], v[28:31]
  v_mfma_f32_16x16x16_bf16 v[32:35], v[66:67], v[114:115], v[32:35]
  s_waitcnt vmcnt(7)
  v_mfma_f32_16x16x16_bf16 v[28:31], v[68:69], v[116:117], v[28:31]
  v_mfma_f32_16x16x16_bf16 v[32:35], v[68:69], v[118:119], v[32:35]
  s_waitcnt vmcnt(6)
  v_mfma_f32_16x16x16_bf16 v[28:31], v[70:71], v[120:121], v[28:31]
  v_mfma_f32_16x16x16_bf16 v[32:35], v[70:71], v[122:123], v[32:35]
  s_waitcnt vmcnt(5)
  v_mfma_f32_16x16x16_bf16 v[28:31], v[72:73], v[124:125], v[28:31]
  v_mfma_f32_16x16x16_bf16 v[32:35], v[72:73], v[126:127], v[32:35]
  s_waitcnt vmcnt(4)
  v_mfma_f32_16x16x16_bf16 v[28:31], v[74:75], v[128:129], v[28:31]
  v_mfma_f32_16x16x16_bf16 v[32:35], v[74:75], v[130:131], v[32:35]
  s_waitcnt vmcnt(3)
  v_mfma_f32_16x16x16_bf16 v[28:31], v[76:77], v[132:133], v[28:31]
  v_mfma_f32_16x16x16_bf16 v[32:35], v[76:77], v[134:135], v[32:35]
  s_waitcnt vmcnt(2)
  v_mfma_f32_16x16x16_bf16 v[28:31], v[78:79], v[136:137], v[28:31]
  v_mfma_f32_16x16x16_bf16 v[32:35], v[78:79], v[138:139], v[32:35]
  s_waitcnt vmcnt(1)
  v_mfma_f32_16x16x16_bf16 v[28:31], v[80:81], v[140:141], v[28:31]
  v_mfma_f32_16x16x16_bf16 v[32:35], v[80:81], v[142:143], v[32:35]
  s_waitcnt vmcnt(0)
  v_mfma_f32_16x16x16_bf16 v[28:31], v[82:83], v[144:145], v[28:31]
  v_mfma_f32_16x16x16_bf16 v[32:35], v[82:83], v[146:147], v[32:35]
  s_branch L_tail
.section .rodata,"a"
.p2align 6
.amdhsa_kernel standalone__paged_block_table_kv_radixattention__decode_kernel
  .amdhsa_next_free_vgpr 156
  .amdhsa_next_free_sgpr 102
  .amdhsa_accum_offset 156
  .amdhsa_group_segment_fixed_size 0
  .amdhsa_kernarg_size 64
  .amdhsa_user_sgpr_count 2
  .amdhsa_user_sgpr_kernarg_segment_ptr 1
  .amdhsa_system_sgpr_workgroup_id_x 1
.end_amdhsa_kernel
```
